```python
import torch

def _softmax(x, axis=-1):
    return torch.softmax(x, dim=axis)
def _gelu(x):
    return torch.nn.functional.gelu(x, approximate="tanh")
def _silu(x):
    return torch.nn.functional.silu(x)
def _sigmoid(x):
    return torch.sigmoid(x)
def _layernorm(x, axis=-1, eps=1e-5):
    m = x.mean(dim=axis, keepdim=True)
    v = x.var(dim=axis, keepdim=True, unbiased=False)
    return (x - m) / torch.sqrt(v + eps)
def _scatter_add(tgt, idx, src, axis=0):
    return tgt.clone().index_add_(axis, idx, src)
def _segment_sum(src, seg, n):
    out = torch.zeros((n,) + src.shape[1:], dtype=src.dtype)
    return out.index_add_(0, seg, src)
def _pad(x, pw):
    flat = tuple(v for pair in reversed(pw) for v in pair)
    return torch.nn.functional.pad(x, flat)

kernel_name = 'standalone__glu_gated_geglu__sampling'

def setup_inputs():

    _w = (lambda a: (lambda t: t.to(torch.bfloat16) if t.is_floating_point() else t)(torch.as_tensor(a)))
    B, S, Dm, Df = 8, 8, 1024, 3584
    return {
        "x": _w((lambda *s: torch.randn(*s, dtype=torch.bfloat16) * 0.05)(B, S, Dm)),
        "w_gate": _w((lambda *s: torch.randn(*s, dtype=torch.bfloat16) * 0.05)(Dm, Df) * (Dm ** -0.5)),
        "w_up": _w((lambda *s: torch.randn(*s, dtype=torch.bfloat16) * 0.05)(Dm, Df) * (Dm ** -0.5)),
        "w_down": _w((lambda *s: torch.randn(*s, dtype=torch.bfloat16) * 0.05)(Df, Dm) * (Df ** -0.5)),
    }

def reference(x, w_gate, w_up, w_down):
    g = torch.einsum("bsd,df->bsf", x, w_gate)
    u = torch.einsum("bsd,df->bsf", x, w_up)
    h = _gelu(g) * u
    return torch.einsum("bsf,fd->bsd", h, w_down)
```

```asm
; @launch grid=(256,1,1) block=(256,1,1) lds=159744
.amdgcn_target "amdgcn-amd-amdhsa--gfx950"
.text
.globl standalone__glu_gated_geglu__sampling_kernel
.p2align 8
.type standalone__glu_gated_geglu__sampling_kernel,@function
standalone__glu_gated_geglu__sampling_kernel:
    s_cmp_ge_u32 s2, 256
    s_cbranch_scc1 L_end
    s_load_dwordx8 s[4:11], s[0:1], 0
    s_load_dwordx2 s[14:15], s[0:1], 48
    s_load_dwordx4 s[96:99], s[0:1], 32
    s_getpc_b64 s[24:25]
L_pc:
    s_mov_b32 s26, L_end-L_pc
    s_mov_b32 s27, 0x00020000
    v_lshlrev_b32 v201, 7, v0
    buffer_load_dword v201, v201, s[24:27], 0 offen
    v_lshrrev_b32 v28, 6, v0
    v_and_b32 v1, 63, v0
    s_and_b32 s40, s2, 7
    v_readfirstlane_b32 s63, v28
    s_lshr_b32 s41, s2, 3
    s_and_b32 s42, s41, 3
    s_lshr_b32 s43, s41, 2
    s_mul_i32 s50, s40, 7
    s_add_u32 s43, s43, s50
    s_and_b32 s44, s41, 15
    s_lshr_b32 s45, s41, 4
    v_lshrrev_b32 v28, 3, v1
    v_bfe_u32 v29, v1, 1, 2
    v_bfe_u32 v30, v1, 4, 1
    s_and_b32 s50, s63, 1
    s_lshl_b32 s50, s50, 1
    v_or_b32 v30, s50, v30
    v_xor_b32 v29, v29, v30
    v_lshlrev_b32 v29, 5, v29
    v_and_b32 v30, 1, v1
    v_lshl_or_b32 v29, v30, 4, v29
    v_mul_u32_u24 v2, 7168, v28
    v_add_u32 v2, v2, v29
    v_lshlrev_b32 v5, 11, v28
    v_add_u32 v5, v5, v29
    s_lshr_b32 s50, s42, 1
    s_lshl_b32 s50, s50, 9
    s_lshl_b32 s51, s63, 3
    s_add_u32 s50, s50, s51
    s_mul_i32 s50, s50, 7168
    s_lshl_b32 s52, s43, 7
    s_add_u32 s50, s50, s52
    v_add_u32 v2, s50, v2
    s_mul_i32 s50, s40, 448
    s_mul_i32 s52, s45, 224
    s_add_u32 s50, s50, s52
    s_add_u32 s50, s50, s51
    s_lshl_b32 s50, s50, 11
    s_lshl_b32 s52, s44, 7
    s_add_u32 s50, s50, s52
    v_add_u32 v5, s50, v5
    v_lshrrev_b32 v29, 2, v1
    v_bfe_u32 v30, v1, 1, 1
    v_lshrrev_b32 v31, 5, v1
    v_xor_b32 v30, v30, v31
    v_lshlrev_b32 v30, 5, v30
    v_lshl_or_b32 v30, v29, 11, v30
    v_and_b32 v31, 1, v1
    v_lshl_or_b32 v5, v31, 4, v30
    s_mul_i32 s50, s40, 448
    s_lshl_b32 s52, s63, 4
    s_add_u32 s50, s50, s52
    s_lshl_b32 s50, s50, 11
    s_lshl_b32 s52, s41, 6
    s_add_u32 s50, s50, s52
    v_add_u32 v5, s50, v5
    v_lshrrev_b32 v29, 4, v1
    v_and_b32 v30, 7, v1
    v_xor_b32 v29, v29, v30
    v_lshlrev_b32 v29, 4, v29
    v_lshl_or_b32 v3, v28, 11, v29
    s_lshl_b32 s50, s63, 15
    s_lshr_b32 s52, s42, 1
    s_lshl_b32 s52, s52, 10
    s_add_u32 s50, s50, s52
    v_add_u32 v3, s50, v3
    v_xor_b32 v4, 64, v3
    v_add_u32 v4, 0x4000, v4
    s_mul_i32 s50, s40, 14
    s_lshr_b32 s51, s41, 2
    s_lshl_b32 s51, s51, 1
    s_add_u32 s50, s50, s51
    s_lshr_b32 s51, s63, 1
    s_add_u32 s50, s50, s51
    s_lshl_b32 s50, s50, 2
    s_add_u32 s50, s50, s42
    s_lshl_b32 s50, s50, 10
    s_and_b32 s51, s63, 1
    s_lshl_b32 s51, s51, 9
    s_add_u32 s50, s50, s51
    s_add_u32 s50, s50, 252706816
    v_and_b32 v29, 15, v1
    v_lshlrev_b32 v29, 4, v29
    v_lshrrev_b32 v30, 5, v1
    v_lshl_or_b32 v21, v30, 8, v29
    v_add_u32 v21, s50, v21
    s_getreg_b32 s84, hwreg(HW_REG_XCC_ID)
    s_lshl_b32 s85, s63, 10
    s_lshl_b32 s86, s63, 11
    s_lshr_b32 s50, s41, 2
    s_mul_i32 s51, s40, 0
    s_add_u32 s50, s50, s51
    s_and_b32 s51, s42, 1
    s_mul_i32 s51, s51, 0
    s_add_u32 s50, s50, s51
    s_and_b32 s50, s50, 0
    s_mul_i32 s87, s50, 458752
    s_mul_i32 s62, s50, 128
    s_mov_b32 s89, 0
    s_mov_b32 s88, 0
    s_and_b32 s84, s84, 7
    v_mov_b32 v44, -1
    v_mov_b32 v40, 0
    v_mov_b32 v45, -1
    v_mov_b32 v41, 0
    v_mov_b32 v46, -1
    v_mov_b32 v42, 0
    v_mov_b32 v47, -1
    v_mov_b32 v43, 0
    s_and_b32 s50, s42, 1
    s_cmp_eq_u32 s50, 0
    s_waitcnt lgkmcnt(0)
    s_cselect_b32 s6, s6, s8
    s_cselect_b32 s7, s7, s9
    s_mov_b32 s50, 251658240
    s_load_dword s48, s[14:15], s50
    s_lshl_b32 s101, s40, 7
    s_add_u32 s101, s101, 251760640
    s_load_dword s100, s[14:15], s101
    s_mov_b32 s20, s6
    s_mov_b32 s21, s7
    s_mov_b32 s22, 7340032
    s_mov_b32 s23, 0x00020000
    s_mov_b32 s16, s4
    s_mov_b32 s17, s5
    s_mov_b32 s18, 131072
    s_mov_b32 s19, 0x00020000
    s_mov_b32 s36, s14
    s_mov_b32 s37, s15
    s_mov_b32 s38, 268435456
    s_mov_b32 s39, 0x00020000
    s_mov_b32 s28, s10
    s_mov_b32 s29, s11
    s_mov_b32 s30, 7340032
    s_mov_b32 s31, 0x00020000
    s_mov_b32 s32, s96
    s_mov_b32 s33, s97
    s_mov_b32 s34, 131072
    s_mov_b32 s35, 0x00020000
    s_cmp_ge_u32 s41, 28
    s_cbranch_scc1 L_spare
    s_add_u32 m0, s85, 0
    s_nop 0
    buffer_load_dwordx4 v2, s[20:23], s87 offen lds
    s_add_u32 m0, s85, 4096
    s_add_u32 s87, s87, 229376
    buffer_load_dwordx4 v2, s[20:23], s87 offen lds
    s_add_u32 m0, s86, 65536
    s_nop 0
    buffer_load_dwordx4 v3, s[16:19], s62 offen lds
    s_add_u32 m0, s86, 66560
    s_nop 0
    buffer_load_dwordx4 v4, s[16:19], s62 offen lds
    s_add_u32 m0, s85, 8192
    s_add_u32 s87, s87, 229376
    s_cmp_eq_u32 s87, 3670016
    s_cselect_b32 s87, 0, s87
    buffer_load_dwordx4 v2, s[20:23], s87 offen lds
    s_add_u32 m0, s85, 12288
    s_add_u32 s87, s87, 229376
    buffer_load_dwordx4 v2, s[20:23], s87 offen lds
    s_add_u32 m0, s86, 73728
    s_add_u32 s62, s62, 128
    s_and_b32 s62, s62, 1023
    buffer_load_dwordx4 v3, s[16:19], s62 offen lds
    s_add_u32 m0, s86, 74752
    s_nop 0
    buffer_load_dwordx4 v4, s[16:19], s62 offen lds
    s_add_u32 m0, s85, 16384
    s_add_u32 s87, s87, 229376
    s_cmp_eq_u32 s87, 3670016
    s_cselect_b32 s87, 0, s87
    buffer_load_dwordx4 v2, s[20:23], s87 offen lds
    s_add_u32 m0, s85, 20480
    s_add_u32 s87, s87, 229376
    buffer_load_dwordx4 v2, s[20:23], s87 offen lds
    s_add_u32 m0, s86, 81920
    s_add_u32 s62, s62, 128
    s_and_b32 s62, s62, 1023
    buffer_load_dwordx4 v3, s[16:19], s62 offen lds
    s_add_u32 m0, s86, 82944
    s_nop 0
    buffer_load_dwordx4 v4, s[16:19], s62 offen lds
    s_add_u32 m0, s85, 24576
    s_add_u32 s87, s87, 229376
    s_cmp_eq_u32 s87, 3670016
    s_cselect_b32 s87, 0, s87
    buffer_load_dwordx4 v2, s[20:23], s87 offen lds
    s_add_u32 m0, s85, 28672
    s_add_u32 s87, s87, 229376
    buffer_load_dwordx4 v2, s[20:23], s87 offen lds
    s_add_u32 m0, s86, 90112
    s_add_u32 s62, s62, 128
    s_and_b32 s62, s62, 1023
    buffer_load_dwordx4 v3, s[16:19], s62 offen lds
    s_add_u32 m0, s86, 91136
    s_nop 0
    buffer_load_dwordx4 v4, s[16:19], s62 offen lds
    v_lshrrev_b32 v28, 4, v1
    v_bfe_u32 v29, v1, 2, 2
    v_lshl_or_b32 v29, v28, 3, v29
    v_lshlrev_b32 v29, 7, v29
    v_and_b32 v30, 3, v1
    v_lshl_or_b32 v29, v30, 3, v29
    v_bfe_u32 v30, v1, 3, 2
    v_xor_b32 v31, s63, v30
    v_lshl_or_b32 v6, v31, 5, v29
    v_bfe_u32 v29, v1, 2, 2
    v_lshl_or_b32 v29, v28, 3, v29
    v_lshlrev_b32 v29, 6, v29
    v_and_b32 v30, 3, v1
    v_lshl_or_b32 v29, v30, 3, v29
    v_add_u32 v29, 131072, v29
    v_and_b32 v30, 1, v28
    v_lshl_or_b32 v16, v30, 5, v29
    v_xor_b32 v17, 32, v16
    v_lshlrev_b32 v22, 4, v1
    s_mul_i32 s50, s40, 56
    s_add_u32 s50, s50, s63
    s_lshl_b32 s50, s50, 10
    s_add_u32 s58, s50, 252706816
    v_bfe_u32 v29, v1, 3, 1
    v_lshlrev_b32 v29, 13, v29
    v_lshl_or_b32 v29, v28, 7, v29
    v_and_b32 v30, 7, v1
    v_lshl_or_b32 v23, v30, 4, v29
    s_lshl_b32 s50, s41, 2
    s_add_u32 s50, s50, s63
    s_lshl_b32 s50, s50, 4
    s_add_u32 s50, s50, s40
    s_lshl_b32 s50, s50, 10
    s_add_u32 s59, s50, 260046848
    s_lshl_b32 s50, s41, 3
    s_add_u32 s50, s50, s40
    s_lshl_b32 s50, s50, 13
    s_lshl_b32 s51, s63, 8
    s_add_u32 s50, s50, s51
    s_add_u32 s60, s50, 260046848
    v_and_b32 v29, 15, v1
    v_lshlrev_b32 v29, 4, v29
    v_lshl_or_b32 v24, v28, 10, v29
    v_bfe_u32 v29, v1, 3, 1
    v_lshlrev_b32 v29, 3, v29
    v_lshl_or_b32 v29, v28, 1, v29
    v_lshl_or_b32 v25, v30, 11, v29
    s_lshl_b32 s50, s40, 14
    s_lshl_b32 s51, s41, 6
    s_add_u32 s50, s50, s51
    s_lshl_b32 s51, s63, 4
    s_add_u32 s50, s50, s51
    v_add_u32 v25, s50, v25
    s_lshl_b32 s50, s40, 7
    s_add_u32 s50, s50, 251756544
    v_mov_b32 v26, s50
    s_mov_b32 s61, 4294966272
    v_and_b32 v39, 31, v1
    s_add_u32 s50, s50, 4096
    v_lshl_add_u32 v39, v39, 2, s50
    v_lshrrev_b32 v28, 4, v1
    v_bfe_u32 v29, v1, 1, 3
    v_xor_b32 v28, v28, v29
    v_lshlrev_b32 v28, 4, v28
    v_and_b32 v29, 15, v1
    v_lshl_or_b32 v28, v29, 7, v28
    s_xor_b32 s50, s42, 0
    s_lshl_b32 s50, s50, 11
    s_add_u32 s50, s50, 65536
    v_add_u32 v8, s50, v28
    v_xor_b32 v9, 64, v8
    s_xor_b32 s50, s42, 1
    s_lshl_b32 s50, s50, 11
    s_add_u32 s50, s50, 65536
    v_add_u32 v10, s50, v28
    v_xor_b32 v11, 64, v10
    s_xor_b32 s50, s42, 2
    s_lshl_b32 s50, s50, 11
    s_add_u32 s50, s50, 65536
    v_add_u32 v12, s50, v28
    v_xor_b32 v13, 64, v12
    s_xor_b32 s50, s42, 3
    s_lshl_b32 s50, s50, 11
    s_add_u32 s50, s50, 65536
    v_add_u32 v14, s50, v28
    v_xor_b32 v15, 64, v14
    v_lshlrev_b32 v20, 4, v1
    s_lshl_b32 s50, s63, 10
    v_add_u32 v20, s50, v20
    s_lshl_b32 s50, s43, 2
    s_xor_b32 s51, s42, 1
    s_add_u32 s51, s51, s50
    s_mul_i32 s51, s51, 12288
    s_add_u32 s54, s51, 253755392
    s_xor_b32 s51, s42, 2
    s_add_u32 s51, s51, s50
    s_mul_i32 s51, s51, 12288
    s_add_u32 s55, s51, 253759488
    s_xor_b32 s51, s42, 3
    s_add_u32 s51, s51, s50
    s_mul_i32 s51, s51, 12288
    s_add_u32 s56, s51, 253763584
    s_add_u32 s51, s50, s42
    s_mul_i32 s51, s51, 12288
    s_add_u32 s57, s51, 253755392
    v_lshrrev_b32 v28, 3, v1
    v_lshlrev_b32 v28, 12, v28
    v_and_b32 v29, 7, v1
    v_lshl_or_b32 v38, v29, 7, v28
    s_lshl_b32 s50, s63, 10
    v_add_u32 v38, s50, v38
    s_waitcnt lgkmcnt(0)
    s_add_u32 s47, s48, 0x1e3779b9
    s_lshl_b32 s47, s47, 4
    s_or_b32 s47, s47, s84
    s_add_u32 s46, s48, 0x29a
    s_and_b32 s46, s46, 1022
    s_or_b32 s46, s46, 1
    v_mov_b32 v7, s46
    s_lshl_b32 s50, s41, 2
    s_add_u32 s50, s101, s50
    s_cmp_eq_u32 s63, 0
    s_cselect_b32 s50, s50, 0x7ffffff0
    v_mov_b32 v32, s50
    v_mov_b32 v33, s47
    s_mov_b64 exec, 1
    buffer_store_dword v33, v32, s[36:39], 0 offen
    s_mov_b64 exec, -1
    s_waitcnt vmcnt(13)
    s_barrier
    ds_read_b64_tr_b16 v[112:113], v6 offset:0
    ds_read_b64_tr_b16 v[114:115], v6 offset:512
    ds_read_b64_tr_b16 v[116:117], v6 offset:4096
    ds_read_b64_tr_b16 v[118:119], v6 offset:4608
    ds_read_b128 v[84:87], v10 offset:0
    ds_read_b128 v[88:91], v12 offset:0
    ds_read_b128 v[92:95], v14 offset:0
    ds_read_b128 v[80:83], v8 offset:0
    ds_read_b128 v[100:103], v11 offset:0
    ds_read_b128 v[104:107], v13 offset:0
    ds_read_b128 v[108:111], v15 offset:0
    ds_read_b128 v[96:99], v9 offset:0
    s_add_u32 m0, s85, 32768
    s_add_u32 s87, s87, 229376
    s_cmp_eq_u32 s87, 3670016
    s_cselect_b32 s87, 0, s87
    buffer_load_dwordx4 v2, s[20:23], s87 offen lds
    s_add_u32 m0, s85, 36864
    s_add_u32 s87, s87, 229376
    buffer_load_dwordx4 v2, s[20:23], s87 offen lds
    s_add_u32 m0, s86, 98304
    s_add_u32 s62, s62, 128
    s_and_b32 s62, s62, 1023
    buffer_load_dwordx4 v3, s[16:19], s62 offen lds
    s_add_u32 m0, s86, 99328
    s_nop 0
    buffer_load_dwordx4 v4, s[16:19], s62 offen lds
    s_waitcnt lgkmcnt(0)
    v_mfma_f32_16x16x32_bf16 v[68:71], v[112:115], v[84:87], 0
    v_mfma_f32_16x16x32_bf16 v[72:75], v[112:115], v[88:91], 0
    v_mfma_f32_16x16x32_bf16 v[76:79], v[112:115], v[92:95], 0
    v_mfma_f32_16x16x32_bf16 v[64:67], v[112:115], v[80:83], 0
    v_mfma_f32_16x16x32_bf16 v[68:71], v[116:119], v[100:103], v[68:71]
    v_mfma_f32_16x16x32_bf16 v[72:75], v[116:119], v[104:107], v[72:75]
    v_mfma_f32_16x16x32_bf16 v[76:79], v[116:119], v[108:111], v[76:79]
    v_mfma_f32_16x16x32_bf16 v[64:67], v[116:119], v[96:99], v[64:67]
    s_waitcnt vmcnt(13)
    s_barrier
    ds_read_b64_tr_b16 v[112:113], v6 offset:8192
    ds_read_b64_tr_b16 v[114:115], v6 offset:8704
    ds_read_b64_tr_b16 v[116:117], v6 offset:12288
    ds_read_b64_tr_b16 v[118:119], v6 offset:12800
    ds_read_b128 v[84:87], v10 offset:8192
    ds_read_b128 v[88:91], v12 offset:8192
    ds_read_b128 v[92:95], v14 offset:8192
    ds_read_b128 v[80:83], v8 offset:8192
    ds_read_b128 v[100:103], v11 offset:8192
    ds_read_b128 v[104:107], v13 offset:8192
    ds_read_b128 v[108:111], v15 offset:8192
    ds_read_b128 v[96:99], v9 offset:8192
    s_add_u32 m0, s85, 40960
    s_add_u32 s87, s87, 229376
    s_cmp_eq_u32 s87, 3670016
    s_cselect_b32 s87, 0, s87
    buffer_load_dwordx4 v2, s[20:23], s87 offen lds
    s_add_u32 m0, s85, 45056
    s_add_u32 s87, s87, 229376
    buffer_load_dwordx4 v2, s[20:23], s87 offen lds
    s_add_u32 m0, s86, 106496
    s_add_u32 s62, s62, 128
    s_and_b32 s62, s62, 1023
    buffer_load_dwordx4 v3, s[16:19], s62 offen lds
    s_add_u32 m0, s86, 107520
    s_nop 0
    buffer_load_dwordx4 v4, s[16:19], s62 offen lds
    s_waitcnt lgkmcnt(0)
    v_mfma_f32_16x16x32_bf16 v[68:71], v[112:115], v[84:87], v[68:71]
    v_mfma_f32_16x16x32_bf16 v[72:75], v[112:115], v[88:91], v[72:75]
    v_mfma_f32_16x16x32_bf16 v[76:79], v[112:115], v[92:95], v[76:79]
    v_mfma_f32_16x16x32_bf16 v[64:67], v[112:115], v[80:83], v[64:67]
    v_mfma_f32_16x16x32_bf16 v[68:71], v[116:119], v[100:103], v[68:71]
    v_mfma_f32_16x16x32_bf16 v[72:75], v[116:119], v[104:107], v[72:75]
    v_mfma_f32_16x16x32_bf16 v[76:79], v[116:119], v[108:111], v[76:79]
    v_mfma_f32_16x16x32_bf16 v[64:67], v[116:119], v[96:99], v[64:67]
    s_waitcnt vmcnt(13)
    s_barrier
    ds_read_b64_tr_b16 v[112:113], v6 offset:16384
    ds_read_b64_tr_b16 v[114:115], v6 offset:16896
    ds_read_b64_tr_b16 v[116:117], v6 offset:20480
    ds_read_b64_tr_b16 v[118:119], v6 offset:20992
    ds_read_b128 v[84:87], v10 offset:16384
    ds_read_b128 v[88:91], v12 offset:16384
    ds_read_b128 v[92:95], v14 offset:16384
    ds_read_b128 v[80:83], v8 offset:16384
    ds_read_b128 v[100:103], v11 offset:16384
    ds_read_b128 v[104:107], v13 offset:16384
    ds_read_b128 v[108:111], v15 offset:16384
    ds_read_b128 v[96:99], v9 offset:16384
    s_add_u32 m0, s85, 49152
    s_add_u32 s87, s87, 229376
    s_cmp_eq_u32 s87, 3670016
    s_cselect_b32 s87, 0, s87
    buffer_load_dwordx4 v2, s[20:23], s87 offen lds
    s_add_u32 m0, s85, 53248
    s_add_u32 s87, s87, 229376
    buffer_load_dwordx4 v2, s[20:23], s87 offen lds
    s_add_u32 m0, s86, 114688
    s_add_u32 s62, s62, 128
    s_and_b32 s62, s62, 1023
    buffer_load_dwordx4 v3, s[16:19], s62 offen lds
    s_add_u32 m0, s86, 115712
    s_nop 0
    buffer_load_dwordx4 v4, s[16:19], s62 offen lds
    s_waitcnt lgkmcnt(0)
    v_mfma_f32_16x16x32_bf16 v[68:71], v[112:115], v[84:87], v[68:71]
    v_mfma_f32_16x16x32_bf16 v[72:75], v[112:115], v[88:91], v[72:75]
    v_mfma_f32_16x16x32_bf16 v[76:79], v[112:115], v[92:95], v[76:79]
    v_mfma_f32_16x16x32_bf16 v[64:67], v[112:115], v[80:83], v[64:67]
    v_mfma_f32_16x16x32_bf16 v[68:71], v[116:119], v[100:103], v[68:71]
    v_mfma_f32_16x16x32_bf16 v[72:75], v[116:119], v[104:107], v[72:75]
    v_mfma_f32_16x16x32_bf16 v[76:79], v[116:119], v[108:111], v[76:79]
    v_mfma_f32_16x16x32_bf16 v[64:67], v[116:119], v[96:99], v[64:67]
    s_waitcnt vmcnt(13)
    s_barrier
    ds_read_b64_tr_b16 v[112:113], v6 offset:24576
    ds_read_b64_tr_b16 v[114:115], v6 offset:25088
    ds_read_b64_tr_b16 v[116:117], v6 offset:28672
    ds_read_b64_tr_b16 v[118:119], v6 offset:29184
    ds_read_b128 v[84:87], v10 offset:24576
    ds_read_b128 v[88:91], v12 offset:24576
    ds_read_b128 v[92:95], v14 offset:24576
    ds_read_b128 v[80:83], v8 offset:24576
    ds_read_b128 v[100:103], v11 offset:24576
    ds_read_b128 v[104:107], v13 offset:24576
    ds_read_b128 v[108:111], v15 offset:24576
    ds_read_b128 v[96:99], v9 offset:24576
    s_add_u32 m0, s85, 57344
    s_add_u32 s87, s87, 229376
    s_cmp_eq_u32 s87, 3670016
    s_cselect_b32 s87, 0, s87
    buffer_load_dwordx4 v2, s[20:23], s87 offen lds
    s_add_u32 m0, s85, 61440
    s_add_u32 s87, s87, 229376
    buffer_load_dwordx4 v2, s[20:23], s87 offen lds
    s_add_u32 m0, s86, 122880
    s_add_u32 s62, s62, 128
    s_and_b32 s62, s62, 1023
    buffer_load_dwordx4 v3, s[16:19], s62 offen lds
    s_add_u32 m0, s86, 123904
    s_nop 0
    buffer_load_dwordx4 v4, s[16:19], s62 offen lds
    s_waitcnt lgkmcnt(0)
    v_mfma_f32_16x16x32_bf16 v[68:71], v[112:115], v[84:87], v[68:71]
    v_mfma_f32_16x16x32_bf16 v[72:75], v[112:115], v[88:91], v[72:75]
    v_mfma_f32_16x16x32_bf16 v[76:79], v[112:115], v[92:95], v[76:79]
    v_mfma_f32_16x16x32_bf16 v[64:67], v[112:115], v[80:83], v[64:67]
    v_mfma_f32_16x16x32_bf16 v[68:71], v[116:119], v[100:103], v[68:71]
    v_mfma_f32_16x16x32_bf16 v[72:75], v[116:119], v[104:107], v[72:75]
    v_mfma_f32_16x16x32_bf16 v[76:79], v[116:119], v[108:111], v[76:79]
    v_mfma_f32_16x16x32_bf16 v[64:67], v[116:119], v[96:99], v[64:67]
    s_waitcnt vmcnt(12)
    s_barrier
    ds_read_b64_tr_b16 v[112:113], v6 offset:32768
    ds_read_b64_tr_b16 v[114:115], v6 offset:33280
    ds_read_b64_tr_b16 v[116:117], v6 offset:36864
    ds_read_b64_tr_b16 v[118:119], v6 offset:37376
    ds_read_b128 v[84:87], v10 offset:32768
    ds_read_b128 v[88:91], v12 offset:32768
    ds_read_b128 v[92:95], v14 offset:32768
    ds_read_b128 v[80:83], v8 offset:32768
    ds_read_b128 v[100:103], v11 offset:32768
    ds_read_b128 v[104:107], v13 offset:32768
    ds_read_b128 v[108:111], v15 offset:32768
    ds_read_b128 v[96:99], v9 offset:32768
    s_waitcnt lgkmcnt(0)
    v_mfma_f32_16x16x32_bf16 v[68:71], v[112:115], v[84:87], v[68:71]
    v_mfma_f32_16x16x32_bf16 v[72:75], v[112:115], v[88:91], v[72:75]
    v_mfma_f32_16x16x32_bf16 v[76:79], v[112:115], v[92:95], v[76:79]
    v_mfma_f32_16x16x32_bf16 v[64:67], v[112:115], v[80:83], v[64:67]
    v_mfma_f32_16x16x32_bf16 v[68:71], v[116:119], v[100:103], v[68:71]
    v_mfma_f32_16x16x32_bf16 v[72:75], v[116:119], v[104:107], v[72:75]
    v_mfma_f32_16x16x32_bf16 v[76:79], v[116:119], v[108:111], v[76:79]
    v_mfma_f32_16x16x32_bf16 v[64:67], v[116:119], v[96:99], v[64:67]
    s_waitcnt vmcnt(8)
    s_barrier
    ds_read_b64_tr_b16 v[112:113], v6 offset:40960
    ds_read_b64_tr_b16 v[114:115], v6 offset:41472
    ds_read_b64_tr_b16 v[116:117], v6 offset:45056
    ds_read_b64_tr_b16 v[118:119], v6 offset:45568
    ds_read_b128 v[84:87], v10 offset:40960
    ds_read_b128 v[88:91], v12 offset:40960
    ds_read_b128 v[92:95], v14 offset:40960
    ds_read_b128 v[80:83], v8 offset:40960
    ds_read_b128 v[100:103], v11 offset:40960
    ds_read_b128 v[104:107], v13 offset:40960
    ds_read_b128 v[108:111], v15 offset:40960
    ds_read_b128 v[96:99], v9 offset:40960
    s_waitcnt lgkmcnt(0)
    v_mfma_f32_16x16x32_bf16 v[68:71], v[112:115], v[84:87], v[68:71]
    v_mfma_f32_16x16x32_bf16 v[72:75], v[112:115], v[88:91], v[72:75]
    v_mfma_f32_16x16x32_bf16 v[76:79], v[112:115], v[92:95], v[76:79]
    v_mfma_f32_16x16x32_bf16 v[64:67], v[112:115], v[80:83], v[64:67]
    v_mfma_f32_16x16x32_bf16 v[68:71], v[116:119], v[100:103], v[68:71]
    v_mfma_f32_16x16x32_bf16 v[72:75], v[116:119], v[104:107], v[72:75]
    v_mfma_f32_16x16x32_bf16 v[76:79], v[116:119], v[108:111], v[76:79]
    v_mfma_f32_16x16x32_bf16 v[64:67], v[116:119], v[96:99], v[64:67]
    s_waitcnt vmcnt(4)
    s_barrier
    ds_read_b64_tr_b16 v[112:113], v6 offset:49152
    ds_read_b64_tr_b16 v[114:115], v6 offset:49664
    ds_read_b64_tr_b16 v[116:117], v6 offset:53248
    ds_read_b64_tr_b16 v[118:119], v6 offset:53760
    ds_read_b128 v[84:87], v10 offset:49152
    ds_read_b128 v[88:91], v12 offset:49152
    ds_read_b128 v[92:95], v14 offset:49152
    ds_read_b128 v[80:83], v8 offset:49152
    ds_read_b128 v[100:103], v11 offset:49152
    ds_read_b128 v[104:107], v13 offset:49152
    ds_read_b128 v[108:111], v15 offset:49152
    ds_read_b128 v[96:99], v9 offset:49152
    s_add_u32 m0, s85, 131072
    s_nop 0
    buffer_load_dwordx4 v5, s[28:31], s88 offen lds
    s_add_u32 m0, s85, 135168
    s_add_u32 s88, s88, 131072
    buffer_load_dwordx4 v5, s[28:31], s88 offen lds
    s_waitcnt lgkmcnt(0)
    v_mfma_f32_16x16x32_bf16 v[68:71], v[112:115], v[84:87], v[68:71]
    v_mfma_f32_16x16x32_bf16 v[72:75], v[112:115], v[88:91], v[72:75]
    v_mfma_f32_16x16x32_bf16 v[76:79], v[112:115], v[92:95], v[76:79]
    v_mfma_f32_16x16x32_bf16 v[64:67], v[112:115], v[80:83], v[64:67]
    v_mfma_f32_16x16x32_bf16 v[68:71], v[116:119], v[100:103], v[68:71]
    v_mfma_f32_16x16x32_bf16 v[72:75], v[116:119], v[104:107], v[72:75]
    v_mfma_f32_16x16x32_bf16 v[76:79], v[116:119], v[108:111], v[76:79]
    v_mfma_f32_16x16x32_bf16 v[64:67], v[116:119], v[96:99], v[64:67]
    s_waitcnt vmcnt(2)
    s_barrier
    ds_read_b64_tr_b16 v[112:113], v6 offset:57344
    ds_read_b64_tr_b16 v[114:115], v6 offset:57856
    ds_read_b64_tr_b16 v[116:117], v6 offset:61440
    ds_read_b64_tr_b16 v[118:119], v6 offset:61952
    ds_read_b128 v[84:87], v10 offset:57344
    ds_read_b128 v[88:91], v12 offset:57344
    ds_read_b128 v[92:95], v14 offset:57344
    ds_read_b128 v[80:83], v8 offset:57344
    ds_read_b128 v[100:103], v11 offset:57344
    ds_read_b128 v[104:107], v13 offset:57344
    ds_read_b128 v[108:111], v15 offset:57344
    ds_read_b128 v[96:99], v9 offset:57344
    s_add_u32 m0, s85, 139264
    s_add_u32 s88, s88, 131072
    buffer_load_dwordx4 v5, s[28:31], s88 offen lds
    s_add_u32 m0, s85, 143360
    s_add_u32 s88, s88, 131072
    buffer_load_dwordx4 v5, s[28:31], s88 offen lds
    s_waitcnt lgkmcnt(0)
    v_mfma_f32_16x16x32_bf16 v[68:71], v[112:115], v[84:87], v[68:71]
    v_mfma_f32_16x16x32_bf16 v[72:75], v[112:115], v[88:91], v[72:75]
    v_mfma_f32_16x16x32_bf16 v[76:79], v[112:115], v[92:95], v[76:79]
    v_mfma_f32_16x16x32_bf16 v[64:67], v[112:115], v[80:83], v[64:67]
    v_mfma_f32_16x16x32_bf16 v[68:71], v[116:119], v[100:103], v[68:71]
    v_mfma_f32_16x16x32_bf16 v[72:75], v[116:119], v[104:107], v[72:75]
    v_mfma_f32_16x16x32_bf16 v[76:79], v[116:119], v[108:111], v[76:79]
    v_mfma_f32_16x16x32_bf16 v[64:67], v[116:119], v[96:99], v[64:67]
    s_nop 5
    v_and_or_b32 v68, v68, s61, v7
    v_and_or_b32 v69, v69, s61, v7
    v_and_or_b32 v70, v70, s61, v7
    v_and_or_b32 v71, v71, s61, v7
    buffer_store_dwordx4 v[68:71], v20, s[36:39], s54 offen
    v_and_or_b32 v72, v72, s61, v7
    v_and_or_b32 v73, v73, s61, v7
    v_and_or_b32 v74, v74, s61, v7
    v_and_or_b32 v75, v75, s61, v7
    buffer_store_dwordx4 v[72:75], v20, s[36:39], s55 offen
    v_and_or_b32 v76, v76, s61, v7
    v_and_or_b32 v77, v77, s61, v7
    v_and_or_b32 v78, v78, s61, v7
    v_and_or_b32 v79, v79, s61, v7
    buffer_store_dwordx4 v[76:79], v20, s[36:39], s56 offen
    s_mov_b32 s49, 30000
    s_add_u32 s50, s57, 0
    buffer_load_dwordx4 v[96:99], v20, s[36:39], s50 offen sc1
    s_add_u32 s50, s57, 4096
    buffer_load_dwordx4 v[100:103], v20, s[36:39], s50 offen sc1
    s_add_u32 s50, s57, 8192
    buffer_load_dwordx4 v[104:107], v20, s[36:39], s50 offen sc1
    buffer_load_dword v27, v39, s[36:39], 0 offen sc1
    s_add_u32 m0, s85, 147456
    s_add_u32 s88, s88, 131072
    buffer_load_dwordx4 v5, s[28:31], s88 offen lds
    s_add_u32 m0, s85, 151552
    s_add_u32 s88, s88, 131072
    buffer_load_dwordx4 v5, s[28:31], s88 offen lds
    s_add_u32 m0, s85, 155648
    s_add_u32 s88, s88, 131072
    buffer_load_dwordx4 v5, s[28:31], s88 offen lds
    s_waitcnt vmcnt(3)
L_hopA_chk:
    v_cmp_ne_u32 vcc, s47, v27
    s_cbranch_vccz L_hopA_c2
    s_cmp_lg_u32 s89, 0
    s_cbranch_scc1 L_hopA_c2
    s_mov_b32 s89, 1
    buffer_store_dwordx4 v[68:71], v20, s[36:39], s54 offen sc1
    buffer_store_dwordx4 v[72:75], v20, s[36:39], s55 offen sc1
    buffer_store_dwordx4 v[76:79], v20, s[36:39], s56 offen sc1
    s_lshl_b32 s50, s40, 5
    s_add_u32 s50, s50, s41
    s_lshl_b32 s50, s50, 7
    s_add_u32 s50, s50, 251723776
    s_cmp_eq_u32 s63, 0
    s_cselect_b32 s50, s50, 0x7ffffff0
    v_mov_b32 v32, s50
    v_mov_b32 v33, s47
    s_mov_b64 exec, 1
    buffer_store_dword v33, v32, s[36:39], 0 offen sc1
    s_mov_b64 exec, -1
L_hopA_c2:
    v_xor_b32 v28, v7, v96
    v_bitop3_b32 v28, v28, v97, v7 bitop3:0xf6
    v_bitop3_b32 v28, v28, v98, v7 bitop3:0xf6
    v_bitop3_b32 v28, v28, v99, v7 bitop3:0xf6
    v_and_b32 v28, 1023, v28
    v_cmp_ne_u32 s[4:5], 0, v28
    v_xor_b32 v28, v7, v100
    v_bitop3_b32 v28, v28, v101, v7 bitop3:0xf6
    v_bitop3_b32 v28, v28, v102, v7 bitop3:0xf6
    v_bitop3_b32 v28, v28, v103, v7 bitop3:0xf6
    v_and_b32 v28, 1023, v28
    v_cmp_ne_u32 s[6:7], 0, v28
    v_xor_b32 v28, v7, v104
    v_bitop3_b32 v28, v28, v105, v7 bitop3:0xf6
    v_bitop3_b32 v28, v28, v106, v7 bitop3:0xf6
    v_bitop3_b32 v28, v28, v107, v7 bitop3:0xf6
    v_and_b32 v28, 1023, v28
    v_cmp_ne_u32 s[8:9], 0, v28
    s_or_b64 vcc, s[4:5], s[6:7]
    s_or_b64 vcc, vcc, s[8:9]
    s_cbranch_scc0 L_hopA_done
    s_add_u32 s50, s57, 0
    s_mov_b64 exec, s[4:5]
    buffer_load_dwordx4 v[96:99], v20, s[36:39], s50 offen sc1
    s_add_u32 s50, s57, 4096
    s_mov_b64 exec, s[6:7]
    buffer_load_dwordx4 v[100:103], v20, s[36:39], s50 offen sc1
    s_add_u32 s50, s57, 8192
    s_mov_b64 exec, s[8:9]
    buffer_load_dwordx4 v[104:107], v20, s[36:39], s50 offen sc1
    s_mov_b64 exec, -1
    buffer_load_dword v27, v39, s[36:39], 0 offen sc1
    s_sub_u32 s49, s49, 1
    s_cmp_lg_u32 s49, 0
    s_waitcnt vmcnt(0)
    s_cbranch_scc1 L_hopA_chk
L_hopA_done:
    v_add_f32 v64, v64, v100
    v_add_f32 v68, v96, v104
    v_add_f32 v65, v65, v101
    v_add_f32 v69, v97, v105
    v_add_f32 v66, v66, v102
    v_add_f32 v70, v98, v106
    v_add_f32 v67, v67, v103
    v_add_f32 v71, v99, v107
    s_bitcmp1_b32 s42, 0
    s_cbranch_scc0 L_nswap
    v_swap_b32 v64, v68
    v_swap_b32 v65, v69
    v_swap_b32 v66, v70
    v_swap_b32 v67, v71
L_nswap:
    v_cvt_pk_bf16_f32 v48, v64, v65
    v_cvt_pk_bf16_f32 v49, v66, v67
    v_cvt_pk_bf16_f32 v50, v68, v69
    v_cvt_pk_bf16_f32 v51, v70, v71
    s_mov_b32 s50, 0xffff0000
    s_mov_b32 s51, 0xbdd2d3e8
    v_mov_b32 v29, 0xc0135761
    v_lshlrev_b32 v64, 16, v48
    v_and_b32 v65, s50, v48
    v_lshlrev_b32 v66, 16, v49
    v_and_b32 v67, s50, v49
    v_mul_f32 v52, v64, v64
    v_mul_f32 v53, v65, v65
    v_mul_f32 v54, v66, v66
    v_mul_f32 v55, v67, v67
    v_fma_f32 v52, v52, s51, v29
    v_fma_f32 v53, v53, s51, v29
    v_fma_f32 v54, v54, s51, v29
    v_fma_f32 v55, v55, s51, v29
    v_mul_f32 v52, v52, v64
    v_mul_f32 v53, v53, v65
    v_mul_f32 v54, v54, v66
    v_mul_f32 v55, v55, v67
    v_exp_f32 v52, v52
    v_exp_f32 v53, v53
    v_exp_f32 v54, v54
    v_exp_f32 v55, v55
    v_lshlrev_b32 v68, 16, v50
    v_and_b32 v69, s50, v50
    v_lshlrev_b32 v70, 16, v51
    v_and_b32 v71, s50, v51
    v_add_f32 v52, 1.0, v52
    v_add_f32 v53, 1.0, v53
    v_add_f32 v54, 1.0, v54
    v_add_f32 v55, 1.0, v55
    v_rcp_f32 v52, v52
    v_rcp_f32 v53, v53
    v_rcp_f32 v54, v54
    v_rcp_f32 v55, v55
    s_nop 0
    v_mul_f32 v52, v52, v64
    v_mul_f32 v53, v53, v65
    v_mul_f32 v54, v54, v66
    v_mul_f32 v55, v55, v67
    v_cvt_pk_bf16_f32 v48, v52, v53
    v_cvt_pk_bf16_f32 v49, v54, v55
    v_cmp_ne_u32 vcc, s47, v27
    v_lshlrev_b32 v52, 16, v48
    v_and_b32 v53, s50, v48
    v_lshlrev_b32 v54, 16, v49
    v_and_b32 v55, s50, v49
    v_mul_f32 v52, v52, v68
    v_mul_f32 v53, v53, v69
    v_mul_f32 v54, v54, v70
    v_mul_f32 v55, v55, v71
    v_cvt_pk_bf16_f32 v56, v52, v53
    v_cvt_pk_bf16_f32 v57, v54, v55
    v_min_u32 v56, -2, v56
    s_nop 1
    v_permlane16_swap_b32 v56, v58
    v_permlane16_swap_b32 v57, v59
    s_mov_b32 exec_lo, 0xffff
    s_mov_b32 exec_hi, 0xffff
    s_cbranch_vccz L_hfast
    s_mov_b64 exec, -1
    s_mov_b32 s49, 30000
L_hfl:
    buffer_load_dword v27, v26, s[36:39], 0 offen sc1
    s_waitcnt vmcnt(0)
    v_xor_b32 v27, s47, v27
    v_cmp_lt_u32 vcc, 15, v27
    s_cbranch_vccz L_hfl_done
    s_sleep 2
    s_sub_u32 s49, s49, 1
    s_cmp_lg_u32 s49, 0
    s_cbranch_scc1 L_hfl
L_hfl_done:
    s_mov_b32 exec_lo, 0xffff
    s_mov_b32 exec_hi, 0xffff
    buffer_store_dwordx4 v[56:59], v21, s[36:39], 0 offen sc1
    s_mov_b64 exec, -1
    s_branch L_p2
L_hfast:
    buffer_store_dwordx4 v[56:59], v21, s[36:39], 0 offen
    s_mov_b64 exec, -1
    s_branch L_p2
L_spare:
    s_cmp_lt_u32 s63, 2
    s_cbranch_scc1 L_spW_skip
    s_add_u32 s50, s40, 3
    s_and_b32 s50, s50, 7
    s_cmp_eq_u32 s50, 7
    s_cbranch_scc1 L_spW_skip
    s_mul_i32 s51, s40, 7
    s_add_u32 s51, s51, s50
    s_lshl_b32 s51, s51, 7
    s_lshr_b32 s52, s42, 1
    s_mul_i32 s52, s52, 3670016
    s_add_u32 s51, s51, s52
    s_and_b32 s50, s50, 0
    s_sub_u32 s52, s63, 2
    s_mul_i32 s52, s52, 2
    s_add_u32 s50, s50, s52
    s_add_u32 s50, s50, 4
    v_mul_u32_u24 v35, 7168, v1
    s_and_b32 s50, s50, 7
    s_mul_i32 s52, s50, 458752
    s_add_u32 s52, s52, s51
    buffer_load_dword v212, v35, s[20:23], s52 offen
    s_add_u32 s50, s50, 1
    s_and_b32 s50, s50, 7
    s_mul_i32 s52, s50, 458752
    s_add_u32 s52, s52, s51
    buffer_load_dword v213, v35, s[20:23], s52 offen
    s_add_u32 s50, s50, 1
L_spW_skip:
    s_sub_u32 s50, s41, 28
    s_lshl_b32 s50, s50, 2
    s_add_u32 s50, s50, s63
    s_mul_i32 s51, s40, 14
    s_add_u32 s51, s51, s50
    s_lshl_b32 s51, s51, 12
    s_add_u32 s51, s51, 252706816
    s_cmp_lt_u32 s50, 14
    s_cselect_b32 s51, s51, 0x7fffe000
    v_lshlrev_b32 v34, 4, v1
    v_add_u32 v34, s51, v34
    buffer_store_dwordx4 v[44:47], v34, s[36:39], 0 offen offset:0 sc1
    buffer_store_dwordx4 v[44:47], v34, s[36:39], 0 offen offset:1024 sc1
    buffer_store_dwordx4 v[44:47], v34, s[36:39], 0 offen offset:2048 sc1
    buffer_store_dwordx4 v[44:47], v34, s[36:39], 0 offen offset:3072 sc1
    v_lshrrev_b32 v28, 4, v1
    v_bfe_u32 v29, v1, 2, 2
    v_lshl_or_b32 v29, v28, 3, v29
    v_lshlrev_b32 v29, 7, v29
    v_and_b32 v30, 3, v1
    v_lshl_or_b32 v29, v30, 3, v29
    v_bfe_u32 v30, v1, 3, 2
    v_xor_b32 v31, s63, v30
    v_lshl_or_b32 v6, v31, 5, v29
    v_bfe_u32 v29, v1, 2, 2
    v_lshl_or_b32 v29, v28, 3, v29
    v_lshlrev_b32 v29, 6, v29
    v_and_b32 v30, 3, v1
    v_lshl_or_b32 v29, v30, 3, v29
    v_add_u32 v29, 131072, v29
    v_and_b32 v30, 1, v28
    v_lshl_or_b32 v16, v30, 5, v29
    v_xor_b32 v17, 32, v16
    v_lshlrev_b32 v22, 4, v1
    s_mul_i32 s50, s40, 56
    s_add_u32 s50, s50, s63
    s_lshl_b32 s50, s50, 10
    s_add_u32 s58, s50, 252706816
    v_bfe_u32 v29, v1, 3, 1
    v_lshlrev_b32 v29, 13, v29
    v_lshl_or_b32 v29, v28, 7, v29
    v_and_b32 v30, 7, v1
    v_lshl_or_b32 v23, v30, 4, v29
    s_lshl_b32 s50, s41, 2
    s_add_u32 s50, s50, s63
    s_lshl_b32 s50, s50, 4
    s_add_u32 s50, s50, s40
    s_lshl_b32 s50, s50, 10
    s_add_u32 s59, s50, 260046848
    s_lshl_b32 s50, s41, 3
    s_add_u32 s50, s50, s40
    s_lshl_b32 s50, s50, 13
    s_lshl_b32 s51, s63, 8
    s_add_u32 s50, s50, s51
    s_add_u32 s60, s50, 260046848
    v_and_b32 v29, 15, v1
    v_lshlrev_b32 v29, 4, v29
    v_lshl_or_b32 v24, v28, 10, v29
    v_bfe_u32 v29, v1, 3, 1
    v_lshlrev_b32 v29, 3, v29
    v_lshl_or_b32 v29, v28, 1, v29
    v_lshl_or_b32 v25, v30, 11, v29
    s_lshl_b32 s50, s40, 14
    s_lshl_b32 s51, s41, 6
    s_add_u32 s50, s50, s51
    s_lshl_b32 s51, s63, 4
    s_add_u32 s50, s50, s51
    v_add_u32 v25, s50, v25
    s_lshl_b32 s50, s40, 7
    s_add_u32 s50, s50, 251756544
    v_mov_b32 v26, s50
    s_mov_b32 s61, 4294966272
    v_and_b32 v39, 31, v1
    s_add_u32 s50, s50, 4096
    v_lshl_add_u32 v39, v39, 2, s50
    s_waitcnt lgkmcnt(0)
    s_add_u32 s47, s48, 0x1e3779b9
    s_lshl_b32 s47, s47, 4
    s_or_b32 s47, s47, s84
    s_add_u32 s46, s48, 0x29a
    s_and_b32 s46, s46, 1022
    s_or_b32 s46, s46, 1
    v_mov_b32 v7, s46
    s_waitcnt vmcnt(0)
    s_barrier
    s_lshl_b32 s50, s41, 2
    s_add_u32 s50, s101, s50
    s_cmp_eq_u32 s63, 0
    s_cselect_b32 s50, s50, 0x7ffffff0
    v_mov_b32 v32, s50
    v_mov_b32 v33, s47
    s_mov_b64 exec, 1
    buffer_store_dword v33, v32, s[36:39], 0 offen
    s_mov_b64 exec, -1
    s_lshl_b32 s50, s40, 5
    s_add_u32 s50, s50, s41
    s_lshl_b32 s50, s50, 7
    s_add_u32 s50, s50, 251723776
    s_cmp_eq_u32 s63, 0
    s_cselect_b32 s50, s50, 0x7ffffff0
    v_mov_b32 v32, s50
    v_mov_b32 v33, s47
    s_mov_b64 exec, 1
    buffer_store_dword v33, v32, s[36:39], 0 offen sc1
    s_mov_b64 exec, -1
    s_cmp_lg_u32 s41, 28
    s_cbranch_scc1 L_agg_skip
    s_cmp_lg_u32 s63, 0
    s_cbranch_scc1 L_agg_skip
    s_mov_b32 s49, 30000
    v_lshlrev_b32 v28, 7, v1
    s_lshl_b32 s50, s40, 12
    s_add_u32 s50, s50, 251723776
    s_mov_b32 exec_lo, 4294967295
    s_mov_b32 exec_hi, 0
L_agg:
    s_sleep 16
    buffer_load_dword v29, v28, s[36:39], s50 offen sc1
    buffer_load_dword v27, v39, s[36:39], 0 offen sc1
    s_waitcnt vmcnt(0)
    v_cmp_ne_u32 vcc, s47, v27
    s_cbranch_vccz L_agg_done
    v_xor_b32 v29, s47, v29
    v_cmp_lt_u32 vcc, 15, v29
    s_cbranch_vccz L_agg_done
    s_sub_u32 s49, s49, 1
    s_cmp_lg_u32 s49, 0
    s_cbranch_scc1 L_agg
L_agg_done:
    v_mov_b32 v29, s47
    v_mov_b32 v30, v26
    s_mov_b64 exec, 1
    buffer_store_dword v29, v30, s[36:39], 0 offen sc1
    s_mov_b64 exec, -1
L_agg_skip:
    s_cmp_lg_u32 s2, 232
    s_cbranch_scc1 L_upd_skip
    s_cmp_lg_u32 s63, 0
    s_cbranch_scc1 L_upd_skip
    s_mov_b32 s49, 30000
    v_lshlrev_b32 v28, 7, v1
    s_mov_b32 s50, 251756544
    s_mov_b32 exec_lo, 255
    s_mov_b32 exec_hi, 0
L_upd:
    s_sleep 8
    buffer_load_dword v29, v28, s[36:39], s50 offen sc1
    s_waitcnt vmcnt(0)
    v_xor_b32 v29, s47, v29
    v_cmp_lt_u32 vcc, 15, v29
    s_cbranch_vccz L_upd_done
    s_sub_u32 s49, s49, 1
    s_cmp_lg_u32 s49, 0
    s_cbranch_scc1 L_upd
L_upd_done:
    s_add_u32 s51, s48, 2
    v_mov_b32 v29, s51
    v_mov_b32 v30, 251658240
    s_mov_b64 exec, 1
    buffer_store_dword v29, v30, s[36:39], 0 offen sc1
    s_mov_b64 exec, -1
L_upd_skip:
    s_cmp_lg_u32 s63, 1
    s_cbranch_scc1 L_fl_skip
    s_mov_b32 s49, 30000
L_fl:
    s_sleep 16
    buffer_load_dword v36, v39, s[36:39], 0 offen sc1
    buffer_load_dword v27, v26, s[36:39], 0 offen sc1
    s_waitcnt vmcnt(0)
    v_cmp_ne_u32 vcc, s47, v36
    s_cbranch_vccz L_fl_done
    v_xor_b32 v27, s47, v27
    v_cmp_lt_u32 vcc, 15, v27
    s_cbranch_vccz L_fl_done
    s_sub_u32 s49, s49, 1
    s_cmp_lg_u32 s49, 0
    s_cbranch_scc1 L_fl
L_fl_done:
L_fl_skip:
    s_barrier
    buffer_load_dwordx4 v[160:163], v34, s[36:39], 0 offen offset:0 sc1
    buffer_load_dwordx4 v[164:167], v34, s[36:39], 0 offen offset:1024 sc1
    buffer_load_dwordx4 v[168:171], v34, s[36:39], 0 offen offset:2048 sc1
    buffer_load_dwordx4 v[172:175], v34, s[36:39], 0 offen offset:3072 sc1
    s_add_u32 m0, s85, 131072
    s_nop 0
    buffer_load_dwordx4 v5, s[28:31], s88 offen lds
    s_add_u32 m0, s85, 135168
    s_add_u32 s88, s88, 131072
    buffer_load_dwordx4 v5, s[28:31], s88 offen lds
    s_add_u32 m0, s85, 139264
    s_add_u32 s88, s88, 131072
    buffer_load_dwordx4 v5, s[28:31], s88 offen lds
    s_add_u32 m0, s85, 143360
    s_add_u32 s88, s88, 131072
    buffer_load_dwordx4 v5, s[28:31], s88 offen lds
    s_add_u32 m0, s85, 147456
    s_add_u32 s88, s88, 131072
    buffer_load_dwordx4 v5, s[28:31], s88 offen lds
    s_add_u32 m0, s85, 151552
    s_add_u32 s88, s88, 131072
    buffer_load_dwordx4 v5, s[28:31], s88 offen lds
    s_add_u32 m0, s85, 155648
    s_add_u32 s88, s88, 131072
    buffer_load_dwordx4 v5, s[28:31], s88 offen lds
    s_mov_b32 s49, 30000
    s_mov_b64 exec, 1
L_canS:
    s_sleep 16
    s_add_u32 s50, s58, 24576
    buffer_load_dwordx4 v[96:99], v22, s[36:39], s50 offen sc1
    s_waitcnt vmcnt(0)
    v_cmp_eq_u32 vcc, -1, v96
    s_cbranch_vccz L_canS_done
    s_sub_u32 s49, s49, 1
    s_cmp_lg_u32 s49, 0
    s_cbranch_scc1 L_canS
L_canS_done:
    s_mov_b64 exec, -1
L_p2:
    s_add_u32 s50, s58, 0
    buffer_load_dwordx4 v[72:75], v22, s[36:39], s50 offen sc1
    s_add_u32 s50, s58, 4096
    buffer_load_dwordx4 v[76:79], v22, s[36:39], s50 offen sc1
    s_add_u32 s50, s58, 8192
    buffer_load_dwordx4 v[80:83], v22, s[36:39], s50 offen sc1
    s_add_u32 s50, s58, 12288
    buffer_load_dwordx4 v[84:87], v22, s[36:39], s50 offen sc1
    s_add_u32 s50, s58, 16384
    buffer_load_dwordx4 v[88:91], v22, s[36:39], s50 offen sc1
    s_add_u32 s50, s58, 20480
    buffer_load_dwordx4 v[92:95], v22, s[36:39], s50 offen sc1
    s_add_u32 s50, s58, 24576
    buffer_load_dwordx4 v[96:99], v22, s[36:39], s50 offen sc1
    s_add_u32 s50, s58, 28672
    buffer_load_dwordx4 v[100:103], v22, s[36:39], s50 offen sc1
    s_add_u32 s50, s58, 32768
    buffer_load_dwordx4 v[104:107], v22, s[36:39], s50 offen sc1
    s_add_u32 s50, s58, 36864
    buffer_load_dwordx4 v[108:111], v22, s[36:39], s50 offen sc1
    s_add_u32 s50, s58, 40960
    buffer_load_dwordx4 v[112:115], v22, s[36:39], s50 offen sc1
    s_add_u32 s50, s58, 45056
    buffer_load_dwordx4 v[116:119], v22, s[36:39], s50 offen sc1
    s_add_u32 s50, s58, 49152
    buffer_load_dwordx4 v[120:123], v22, s[36:39], s50 offen sc1
    s_add_u32 s50, s58, 53248
    buffer_load_dwordx4 v[124:127], v22, s[36:39], s50 offen sc1
    s_waitcnt vmcnt(14)
    s_barrier
    ds_read_b64_tr_b16 v[128:129], v16 offset:0
    ds_read_b64_tr_b16 v[130:131], v16 offset:256
    ds_read_b64_tr_b16 v[132:133], v17 offset:0
    ds_read_b64_tr_b16 v[134:135], v17 offset:256
    ds_read_b64_tr_b16 v[136:137], v16 offset:2048
    ds_read_b64_tr_b16 v[138:139], v16 offset:2304
    ds_read_b64_tr_b16 v[140:141], v17 offset:2048
    ds_read_b64_tr_b16 v[142:143], v17 offset:2304
    ds_read_b64_tr_b16 v[144:145], v16 offset:4096
    ds_read_b64_tr_b16 v[146:147], v16 offset:4352
    ds_read_b64_tr_b16 v[148:149], v17 offset:4096
    ds_read_b64_tr_b16 v[150:151], v17 offset:4352
    ds_read_b64_tr_b16 v[152:153], v16 offset:6144
    ds_read_b64_tr_b16 v[154:155], v16 offset:6400
    ds_read_b64_tr_b16 v[156:157], v17 offset:6144
    ds_read_b64_tr_b16 v[158:159], v17 offset:6400
    ds_read_b64_tr_b16 v[160:161], v16 offset:8192
    ds_read_b64_tr_b16 v[162:163], v16 offset:8448
    ds_read_b64_tr_b16 v[164:165], v17 offset:8192
    ds_read_b64_tr_b16 v[166:167], v17 offset:8448
    ds_read_b64_tr_b16 v[168:169], v16 offset:10240
    ds_read_b64_tr_b16 v[170:171], v16 offset:10496
    ds_read_b64_tr_b16 v[172:173], v17 offset:10240
    ds_read_b64_tr_b16 v[174:175], v17 offset:10496
    ds_read_b64_tr_b16 v[176:177], v16 offset:12288
    ds_read_b64_tr_b16 v[178:179], v16 offset:12544
    ds_read_b64_tr_b16 v[180:181], v17 offset:12288
    ds_read_b64_tr_b16 v[182:183], v17 offset:12544
    ds_read_b64_tr_b16 v[184:185], v16 offset:14336
    ds_read_b64_tr_b16 v[186:187], v16 offset:14592
    ds_read_b64_tr_b16 v[188:189], v17 offset:14336
    ds_read_b64_tr_b16 v[190:191], v17 offset:14592
    ds_read_b64_tr_b16 v[192:193], v16 offset:16384
    ds_read_b64_tr_b16 v[194:195], v16 offset:16640
    ds_read_b64_tr_b16 v[196:197], v17 offset:16384
    ds_read_b64_tr_b16 v[198:199], v17 offset:16640
    ds_read_b64_tr_b16 v[200:201], v16 offset:18432
    ds_read_b64_tr_b16 v[202:203], v16 offset:18688
    ds_read_b64_tr_b16 v[204:205], v17 offset:18432
    ds_read_b64_tr_b16 v[206:207], v17 offset:18688
    ds_read_b64_tr_b16 v[208:209], v16 offset:20480
    ds_read_b64_tr_b16 v[210:211], v16 offset:20736
    ds_read_b64_tr_b16 v[212:213], v17 offset:20480
    ds_read_b64_tr_b16 v[214:215], v17 offset:20736
    ds_read_b64_tr_b16 v[216:217], v16 offset:22528
    ds_read_b64_tr_b16 v[218:219], v16 offset:22784
    ds_read_b64_tr_b16 v[220:221], v17 offset:22528
    ds_read_b64_tr_b16 v[222:223], v17 offset:22784
    ds_read_b64_tr_b16 v[224:225], v16 offset:24576
    ds_read_b64_tr_b16 v[226:227], v16 offset:24832
    ds_read_b64_tr_b16 v[228:229], v17 offset:24576
    ds_read_b64_tr_b16 v[230:231], v17 offset:24832
    ds_read_b64_tr_b16 v[232:233], v16 offset:26624
    ds_read_b64_tr_b16 v[234:235], v16 offset:26880
    ds_read_b64_tr_b16 v[236:237], v17 offset:26624
    ds_read_b64_tr_b16 v[238:239], v17 offset:26880
    s_mov_b32 s49, 30000
L_hopB:
    s_waitcnt vmcnt(0)
    v_max_u32 v28, v72, v76
    v_cmp_eq_u32 s[4:5], -1, v28
    v_max_u32 v29, v80, v84
    v_cmp_eq_u32 s[6:7], -1, v29
    v_max_u32 v30, v88, v92
    v_cmp_eq_u32 s[8:9], -1, v30
    v_max_u32 v31, v96, v100
    v_cmp_eq_u32 s[10:11], -1, v31
    v_max_u32 v32, v104, v108
    v_cmp_eq_u32 s[12:13], -1, v32
    v_max_u32 v33, v112, v116
    v_cmp_eq_u32 s[82:83], -1, v33
    v_max_u32 v34, v120, v124
    v_cmp_eq_u32 s[92:93], -1, v34
    s_or_b64 vcc, s[4:5], s[6:7]
    s_or_b64 vcc, vcc, s[8:9]
    s_or_b64 vcc, vcc, s[10:11]
    s_or_b64 vcc, vcc, s[12:13]
    s_or_b64 vcc, vcc, s[82:83]
    s_or_b64 vcc, vcc, s[92:93]
    s_cbranch_scc0 L_hopB_done
    s_mov_b64 exec, s[4:5]
    s_add_u32 s50, s58, 0
    buffer_load_dwordx4 v[72:75], v22, s[36:39], s50 offen sc1
    s_add_u32 s50, s58, 4096
    buffer_load_dwordx4 v[76:79], v22, s[36:39], s50 offen sc1
    s_mov_b64 exec, s[6:7]
    s_add_u32 s50, s58, 8192
    buffer_load_dwordx4 v[80:83], v22, s[36:39], s50 offen sc1
    s_add_u32 s50, s58, 12288
    buffer_load_dwordx4 v[84:87], v22, s[36:39], s50 offen sc1
    s_mov_b64 exec, s[8:9]
    s_add_u32 s50, s58, 16384
    buffer_load_dwordx4 v[88:91], v22, s[36:39], s50 offen sc1
    s_add_u32 s50, s58, 20480
    buffer_load_dwordx4 v[92:95], v22, s[36:39], s50 offen sc1
    s_mov_b64 exec, s[10:11]
    s_add_u32 s50, s58, 24576
    buffer_load_dwordx4 v[96:99], v22, s[36:39], s50 offen sc1
    s_add_u32 s50, s58, 28672
    buffer_load_dwordx4 v[100:103], v22, s[36:39], s50 offen sc1
    s_mov_b64 exec, s[12:13]
    s_add_u32 s50, s58, 32768
    buffer_load_dwordx4 v[104:107], v22, s[36:39], s50 offen sc1
    s_add_u32 s50, s58, 36864
    buffer_load_dwordx4 v[108:111], v22, s[36:39], s50 offen sc1
    s_mov_b64 exec, s[82:83]
    s_add_u32 s50, s58, 40960
    buffer_load_dwordx4 v[112:115], v22, s[36:39], s50 offen sc1
    s_add_u32 s50, s58, 45056
    buffer_load_dwordx4 v[116:119], v22, s[36:39], s50 offen sc1
    s_mov_b64 exec, s[92:93]
    s_add_u32 s50, s58, 49152
    buffer_load_dwordx4 v[120:123], v22, s[36:39], s50 offen sc1
    s_add_u32 s50, s58, 53248
    buffer_load_dwordx4 v[124:127], v22, s[36:39], s50 offen sc1
    s_mov_b64 exec, -1
    s_sub_u32 s49, s49, 1
    s_cmp_lg_u32 s49, 0
    s_cbranch_scc1 L_hopB
    s_waitcnt vmcnt(0)
L_hopB_done:
    s_waitcnt lgkmcnt(0)
    v_mfma_f32_16x16x32_bf16 v[48:51], v[128:131], v[72:75], 0
    v_mfma_f32_16x16x32_bf16 v[52:55], v[132:135], v[72:75], 0
    v_mfma_f32_16x16x32_bf16 v[56:59], v[136:139], v[76:79], 0
    v_mfma_f32_16x16x32_bf16 v[60:63], v[140:143], v[76:79], 0
    v_mfma_f32_16x16x32_bf16 v[48:51], v[144:147], v[80:83], v[48:51]
    v_mfma_f32_16x16x32_bf16 v[52:55], v[148:151], v[80:83], v[52:55]
    v_mfma_f32_16x16x32_bf16 v[56:59], v[152:155], v[84:87], v[56:59]
    v_mfma_f32_16x16x32_bf16 v[60:63], v[156:159], v[84:87], v[60:63]
    v_mfma_f32_16x16x32_bf16 v[48:51], v[160:163], v[88:91], v[48:51]
    v_mfma_f32_16x16x32_bf16 v[52:55], v[164:167], v[88:91], v[52:55]
    v_mfma_f32_16x16x32_bf16 v[56:59], v[168:171], v[92:95], v[56:59]
    v_mfma_f32_16x16x32_bf16 v[60:63], v[172:175], v[92:95], v[60:63]
    v_mfma_f32_16x16x32_bf16 v[48:51], v[176:179], v[96:99], v[48:51]
    v_mfma_f32_16x16x32_bf16 v[52:55], v[180:183], v[96:99], v[52:55]
    v_mfma_f32_16x16x32_bf16 v[56:59], v[184:187], v[100:103], v[56:59]
    v_mfma_f32_16x16x32_bf16 v[60:63], v[188:191], v[100:103], v[60:63]
    v_mfma_f32_16x16x32_bf16 v[48:51], v[192:195], v[104:107], v[48:51]
    v_mfma_f32_16x16x32_bf16 v[52:55], v[196:199], v[104:107], v[52:55]
    v_mfma_f32_16x16x32_bf16 v[56:59], v[200:203], v[108:111], v[56:59]
    v_mfma_f32_16x16x32_bf16 v[60:63], v[204:207], v[108:111], v[60:63]
    v_mfma_f32_16x16x32_bf16 v[48:51], v[208:211], v[112:115], v[48:51]
    v_mfma_f32_16x16x32_bf16 v[52:55], v[212:215], v[112:115], v[52:55]
    v_mfma_f32_16x16x32_bf16 v[56:59], v[216:219], v[116:119], v[56:59]
    v_mfma_f32_16x16x32_bf16 v[60:63], v[220:223], v[116:119], v[60:63]
    v_mfma_f32_16x16x32_bf16 v[48:51], v[224:227], v[120:123], v[48:51]
    v_mfma_f32_16x16x32_bf16 v[52:55], v[228:231], v[120:123], v[52:55]
    v_mfma_f32_16x16x32_bf16 v[56:59], v[232:235], v[124:127], v[56:59]
    v_mfma_f32_16x16x32_bf16 v[60:63], v[236:239], v[124:127], v[60:63]
    s_nop 6
    v_add_f32 v48, v48, v56
    v_add_f32 v49, v49, v57
    v_add_f32 v50, v50, v58
    v_add_f32 v51, v51, v59
    v_and_or_b32 v48, v48, s61, v7
    v_and_or_b32 v49, v49, s61, v7
    v_and_or_b32 v50, v50, s61, v7
    v_and_or_b32 v51, v51, s61, v7
    buffer_store_dwordx4 v[48:51], v23, s[36:39], s59 offen offset:0 sc1
    v_add_f32 v52, v52, v60
    v_add_f32 v53, v53, v61
    v_add_f32 v54, v54, v62
    v_add_f32 v55, v55, v63
    v_and_or_b32 v52, v52, s61, v7
    v_and_or_b32 v53, v53, s61, v7
    v_and_or_b32 v54, v54, s61, v7
    v_and_or_b32 v55, v55, s61, v7
    buffer_store_dwordx4 v[52:55], v23, s[36:39], s59 offen offset:512 sc1
    s_sleep 8
    s_mov_b32 s49, 30000
    s_add_u32 s50, s60, 0
    buffer_load_dwordx4 v[96:99], v24, s[36:39], s50 offen sc1
    s_add_u32 s50, s60, 4096
    buffer_load_dwordx4 v[100:103], v24, s[36:39], s50 offen sc1
L_hopC:
    s_waitcnt vmcnt(0)
    v_xor_b32 v28, v7, v96
    v_bitop3_b32 v28, v28, v97, v7 bitop3:0xf6
    v_bitop3_b32 v28, v28, v98, v7 bitop3:0xf6
    v_bitop3_b32 v28, v28, v99, v7 bitop3:0xf6
    v_and_b32 v28, 1023, v28
    v_cmp_ne_u32 s[4:5], 0, v28
    v_xor_b32 v28, v7, v100
    v_bitop3_b32 v28, v28, v101, v7 bitop3:0xf6
    v_bitop3_b32 v28, v28, v102, v7 bitop3:0xf6
    v_bitop3_b32 v28, v28, v103, v7 bitop3:0xf6
    v_and_b32 v28, 1023, v28
    v_cmp_ne_u32 s[6:7], 0, v28
    s_or_b64 vcc, s[4:5], s[6:7]
    s_cbranch_scc0 L_hopC_done
    s_add_u32 s50, s60, 0
    s_mov_b64 exec, s[4:5]
    buffer_load_dwordx4 v[96:99], v24, s[36:39], s50 offen sc1
    s_add_u32 s50, s60, 4096
    s_mov_b64 exec, s[6:7]
    buffer_load_dwordx4 v[100:103], v24, s[36:39], s50 offen sc1
    s_mov_b64 exec, -1
    s_sub_u32 s49, s49, 1
    s_cmp_lg_u32 s49, 0
    s_cbranch_scc1 L_hopC
    s_waitcnt vmcnt(0)
L_hopC_done:
    v_add_f32 v96, v96, v100
    v_add_f32 v97, v97, v101
    v_add_f32 v98, v98, v102
    v_add_f32 v99, v99, v103
    s_nop 1
    v_permlane32_swap_b32 v96, v98
    v_permlane32_swap_b32 v97, v99
    s_nop 1
    v_add_f32 v96, v96, v98
    v_add_f32 v97, v97, v99
    s_nop 1
    v_permlane16_swap_b32 v96, v97
    s_nop 1
    v_add_f32 v96, v96, v97
    v_cvt_pk_bf16_f32 v96, v96, v96
    buffer_store_short v96, v25, s[32:35], 0 offen
L_end:
    s_endpgm
.section .rodata,"a"
.p2align 6
.amdhsa_kernel standalone__glu_gated_geglu__sampling_kernel
  .amdhsa_next_free_vgpr 240
  .amdhsa_next_free_sgpr 102
  .amdhsa_accum_offset 240
  .amdhsa_group_segment_fixed_size 0
  .amdhsa_kernarg_size 56
  .amdhsa_user_sgpr_count 2
  .amdhsa_user_sgpr_kernarg_segment_ptr 1
  .amdhsa_system_sgpr_workgroup_id_x 1
  .amdhsa_float_denorm_mode_32 3
.end_amdhsa_kernel
```
